```python
import torch

def _softmax(x, axis=-1):
    return torch.softmax(x, dim=axis)
def _gelu(x):
    return torch.nn.functional.gelu(x, approximate="tanh")
def _silu(x):
    return torch.nn.functional.silu(x)
def _sigmoid(x):
    return torch.sigmoid(x)
def _layernorm(x, axis=-1, eps=1e-5):
    m = x.mean(dim=axis, keepdim=True)
    v = x.var(dim=axis, keepdim=True, unbiased=False)
    return (x - m) / torch.sqrt(v + eps)
def _scatter_add(tgt, idx, src, axis=0):
    return tgt.clone().index_add_(axis, idx, src)
def _segment_sum(src, seg, n):
    out = torch.zeros((n,) + src.shape[1:], dtype=src.dtype)
    return out.index_add_(0, seg, src)
def _pad(x, pw):
    flat = tuple(v for pair in reversed(pw) for v in pair)
    return torch.nn.functional.pad(x, flat)

kernel_name = 'concat_heads__sliding_block_cached__sliding_block_cached__decode'

def setup_inputs():

    _w = (lambda a: (lambda t: t.to(torch.bfloat16) if t.is_floating_point() else t)(torch.as_tensor(a)))
    def _A_setup():
        B, Sq, D = 1, 1, 640
        Hq, Hkv, Sk, Dh = 32, 32, 8192, 192
        assert Hq % Hkv == 0, (Hq, Hkv)
        return {
            "x": _w((lambda *s: torch.randn(*s, dtype=torch.bfloat16) * 0.8)(B, Sq, D)),
            "k_cache": _w((lambda *s: torch.randn(*s, dtype=torch.bfloat16) * 0.8)(B, Hkv, Sk, Dh)),
            "v_cache": _w((lambda *s: torch.randn(*s, dtype=torch.bfloat16) * 0.05)(B, Hkv, Sk, Dh)),
            "wq": _w((lambda *s: torch.randn(*s, dtype=torch.bfloat16) * 0.8)(D, Hq * Dh) * (D ** -0.5)),
            "wo": _w((lambda *s: torch.randn(*s, dtype=torch.bfloat16) * 0.05)(Hq * Dh, D) * ((Hq * Dh) ** -0.5)),
        }
    _A_in = _A_setup()

    def _B_setup():
        B, Sq, D = 1, 1, 640
        Hq, Hkv, Sk, Dh = 32, 32, 8192, 192
        assert Hq % Hkv == 0, (Hq, Hkv)
        return {
            "x": _w((lambda *s: torch.randn(*s, dtype=torch.bfloat16) * 0.8)(B, Sq, D)),
            "k_cache": _w((lambda *s: torch.randn(*s, dtype=torch.bfloat16) * 0.8)(B, Hkv, Sk, Dh)),
            "v_cache": _w((lambda *s: torch.randn(*s, dtype=torch.bfloat16) * 0.05)(B, Hkv, Sk, Dh)),
            "wq": _w((lambda *s: torch.randn(*s, dtype=torch.bfloat16) * 0.8)(D, Hq * Dh) * (D ** -0.5)),
            "wo": _w((lambda *s: torch.randn(*s, dtype=torch.bfloat16) * 0.05)(Hq * Dh, D) * ((Hq * Dh) ** -0.5)),
        }
    _B_in = _B_setup()

    return {
        "A_x": _A_in["x"],
        "A_k_cache": _A_in["k_cache"],
        "A_v_cache": _A_in["v_cache"],
        "A_wq": _A_in["wq"],
        "A_wo": _A_in["wo"],
        "B_x": _B_in["x"],
        "B_k_cache": _B_in["k_cache"],
        "B_v_cache": _B_in["v_cache"],
        "B_wq": _B_in["wq"],
        "B_wo": _B_in["wo"],
    }

def reference(A_x, A_k_cache, A_v_cache, A_wq, A_wo, B_x, B_k_cache, B_v_cache, B_wq, B_wo):
    def _A_ref(x, k_cache, v_cache, wq, wo):
        B, Sq, D = x.shape
        Hq, Dh = 32, 192
        Hkv, Sk = k_cache.shape[1], k_cache.shape[2]
        W = min(4096, max(256, Sk // 4))
        rep = Hq // Hkv
        q = (lambda x, *d: x.permute(*d))((x @ wq).reshape(B, Sq, Hq, Dh), 0, 2, 1, 3)
        k = (lambda x, n, axis: torch.repeat_interleave(x, n, dim=axis))(k_cache[:, :, Sk - W:, :], rep, axis=1)
        v = (lambda x, n, axis: torch.repeat_interleave(x, n, dim=axis))(v_cache[:, :, Sk - W:, :], rep, axis=1)
        scores = torch.einsum("bhqd,bhkd->bhqk", q, k) * (Dh ** -0.5)
        p = _softmax(scores, axis=-1)
        o = torch.einsum("bhqk,bhkd->bhqd", p, v)
        return (lambda x, *d: x.permute(*d))(o, 0, 2, 1, 3).reshape(B, Sq, Hq * Dh) @ wo

    def _B_ref(x, k_cache, v_cache, wq, wo):
        B, Sq, D = x.shape
        Hq, Dh = 32, 192
        Hkv, Sk = k_cache.shape[1], k_cache.shape[2]
        W = min(4096, max(256, Sk // 4))
        rep = Hq // Hkv
        q = (lambda x, *d: x.permute(*d))((x @ wq).reshape(B, Sq, Hq, Dh), 0, 2, 1, 3)
        k = (lambda x, n, axis: torch.repeat_interleave(x, n, dim=axis))(k_cache[:, :, Sk - W:, :], rep, axis=1)
        v = (lambda x, n, axis: torch.repeat_interleave(x, n, dim=axis))(v_cache[:, :, Sk - W:, :], rep, axis=1)
        scores = torch.einsum("bhqd,bhkd->bhqk", q, k) * (Dh ** -0.5)
        p = _softmax(scores, axis=-1)
        o = torch.einsum("bhqk,bhkd->bhqd", p, v)
        return (lambda x, *d: x.permute(*d))(o, 0, 2, 1, 3).reshape(B, Sq, Hq * Dh) @ wo

    a = _A_ref(A_x, A_k_cache, A_v_cache, A_wq, A_wo)
    b = _B_ref(B_x, B_k_cache, B_v_cache, B_wq, B_wo)
    return torch.concatenate([a, b], axis=-1)
```

```asm
; @launch grid=(256,1,1) block=(512,1,1) lds=14336
.amdgcn_target "amdgcn-amd-amdhsa--gfx950"
.text
.globl concat_heads__sliding_block_cached__sliding_block_cached__decode_kernel
.p2align 8
.type concat_heads__sliding_block_cached__sliding_block_cached__decode_kernel,@function
concat_heads__sliding_block_cached__sliding_block_cached__decode_kernel:
    s_cmp_ge_u32 s2, 256
    s_cbranch_scc1 L_end
    s_and_b32 s56, s2, 1
    s_lshr_b32 s54, s2, 3
    s_bfe_u32 s55, s2, 0x20001
    s_mul_i32 s68, s56, 40
    s_add_u32 s4, s0, s68
    s_addc_u32 s5, s1, 0
    s_load_dwordx4 s[12:15], s[4:5], 24
    s_load_dwordx2 s[6:7], s[4:5], 0
    s_load_dwordx4 s[8:11], s[4:5], 8
    s_load_dwordx4 s[48:51], s[0:1], 80
    s_load_dwordx2 s[52:53], s[0:1], 96
    v_lshrrev_b32 v51, 3, v0
    v_and_b32 v49, 7, v0
    v_lshlrev_b32 v9, 4, v49
    s_movk_i32 s69, 12288
    v_mad_u32_u24 v2, v51, s69, v9
    s_mul_i32 s68, s55, 1966080
    s_mov_b32 s26, 1954176
    s_mul_i32 s69, s54, 384
    s_add_u32 s68, s68, s69
    s_mov_b32 s27, 0x20000
    s_mov_b32 s62, 786432
    v_lshrrev_b32 v14, 6, v0
    v_and_b32 v0, 63, v0
    v_readfirstlane_b32 s58, v14
    s_lshl_b32 s57, s56, 5
    s_add_u32 s57, s57, s54
    s_lshl_b32 s75, s57, 2
    s_add_u32 s75, s75, s55
    s_mul_i32 s75, s75, 4096
    s_mov_b32 s38, 1048576
    s_mov_b32 s39, 0x20000
    s_waitcnt lgkmcnt(0)
    s_add_u32 s24, s12, s68
    s_addc_u32 s25, s13, 0
    buffer_load_dwordx4 v[160:163], v2, s[24:27], 0 offen offset:0 nt
    buffer_load_dwordx4 v[164:167], v2, s[24:27], 0 offen offset:128 nt
    buffer_load_dwordx4 v[168:171], v2, s[24:27], 0 offen offset:256 nt
    s_mov_b32 s36, s52
    s_mov_b32 s37, s53
    v_mov_b32 v60, 0
    v_mov_b32 v61, 0
    v_mov_b32 v62, 0
    v_mov_b32 v63, 0
    ds_write_b128 v60, v[60:63] offset:12992
    v_and_b32 v58, 3, v0
    v_lshlrev_b32 v58, 5, v58
    ds_write_b32 v58, v60 offset:12888
    v_lshlrev_b32 v58, 2, v0
    v_mov_b32 v57, -1
    ds_write_b32 v58, v57 offset:14080
    s_mul_i32 s74, s55, 320
    s_waitcnt lgkmcnt(0)
    s_mov_b32 s32, s6
    s_mov_b32 s33, s7
    s_mov_b32 s34, 1284
    s_mov_b32 s35, 0x20000
    v_lshlrev_b32 v3, 1, v51
    buffer_load_ushort v56, v3, s[32:35], s74 offen
    s_barrier
    s_mov_b32 s63, 1572864
    s_mov_b32 s3, 2359296
    s_mul_i32 s68, s54, 3145728
    s_mul_i32 s69, s55, 196608
    s_add_u32 s68, s68, s69
    s_add_u32 s68, s68, 2359296
    s_add_u32 s16, s8, s68
    s_addc_u32 s17, s9, 0
    s_mov_b32 s18, 196608
    s_mov_b32 s19, 0x20000
    s_add_u32 s20, s10, s68
    s_addc_u32 s21, s11, 0
    s_mov_b32 s22, 196608
    s_mov_b32 s23, 0x20000
    s_lshl_b32 s72, s54, 2
    s_add_u32 s72, s72, s55
    s_mul_i32 s68, s72, 61440
    s_add_u32 s28, s14, s68
    s_addc_u32 s29, s15, 0
    s_mov_b32 s30, 61440
    s_mov_b32 s31, 0x20000
    s_mov_b32 s40, s50
    s_mov_b32 s41, s51
    s_mov_b32 s42, 256
    s_mov_b32 s43, 0x20000
    s_mov_b32 s44, s48
    s_mov_b32 s45, s49
    s_mov_b32 s46, 2564
    s_mov_b32 s47, 0x20000
    s_mov_b32 s59, 6144
    s_mov_b32 s60, 12288
    s_mov_b32 s61, 18432
    s_mov_b32 s64, 5120
    s_mov_b32 s65, 10240
    s_mov_b32 s66, 0x3fb8aa3b
    s_cmp_lt_u32 s72, 20
    s_cselect_b32 s71, s58, 0
    s_lshl_b32 s68, s55, 4
    s_mov_b64 s[6:7], 0x1fff
    s_lshl_b64 s[6:7], s[6:7], s68
    s_mov_b32 s4, 0x1fff1fff
    s_mov_b32 s5, 0x1fff1fff
    s_andn2_b64 s[4:5], s[4:5], s[6:7]
    v_lshrrev_b32 v48, 3, v0
    s_mul_i32 s68, s58, 24576
    v_mul_u32_u24 v1, 384, v48
    v_add3_u32 v1, v1, v9, s68
    v_lshrrev_b32 v52, 4, v0
    v_and_b32 v53, 15, v0
    v_mul_u32_u24 v6, 15360, v52
    v_lshl_add_u32 v6, v53, 4, v6
    s_lshl_b32 s68, s58, 8
    v_add_u32 v6, s68, v6
    v_lshlrev_b32 v5, 5, v52
    v_lshlrev_b32 v4, 5, v53
    v_and_b32 v54, 16, v0
    s_lshl_b32 s68, s58, 9
    v_add3_u32 v4, v4, v54, s68
    v_lshrrev_b32 v54, 5, v0
    v_mul_u32_u24 v7, 768, v54
    v_lshl_add_u32 v7, v49, 5, v7
    v_and_b32 v54, 1, v52
    v_lshl_add_u32 v7, v54, 4, v7
    s_mul_i32 s68, s58, 1536
    v_add_u32 v7, s68, v7
    v_mad_u32_u24 v8, v52, 12, v53
    v_lshlrev_b32 v8, 4, v8
    s_lshl_b32 s68, s58, 2
    v_add_u32 v54, s68, v48
    v_cmp_gt_u32 vcc, 32, v0
    v_mul_u32_u24 v50, 12288, v54
    v_add_u32 v50, v50, v9
    v_lshlrev_b32 v51, 1, v54
    v_mov_b32 v55, 0x7f000000
    v_cndmask_b32 v50, v55, v50, vcc
    v_cndmask_b32 v51, v55, v51, vcc
    v_and_b32 v54, 1, v0
    v_lshlrev_b32 v54, 4, v54
    v_mov_b32 v55, 0xffff
    v_lshlrev_b32 v55, v54, v55
    v_lshrrev_b32 v54, 1, v49
    v_cmp_eq_u32 vcc, 0, v54
    s_nop 1
    v_cndmask_b32 v10, 0, v55, vcc
    v_cmp_eq_u32 vcc, 1, v54
    s_nop 1
    v_cndmask_b32 v11, 0, v55, vcc
    v_cmp_eq_u32 vcc, 2, v54
    s_nop 1
    v_cndmask_b32 v12, 0, v55, vcc
    v_cmp_eq_u32 vcc, 3, v54
    s_nop 1
    v_cndmask_b32 v13, 0, v55, vcc
    s_cmp_lg_u32 s58, 5
    s_cbranch_scc1 L_noreset
    v_mov_b32 v36, -1
    v_mov_b32 v37, -1
    v_mov_b32 v38, -1
    v_mov_b32 v39, -1
    v_lshlrev_b32 v14, 4, v0
    buffer_store_dwordx4 v[36:39], v14, s[36:39], s75 offen offset:0 sc1
    buffer_store_dwordx4 v[36:39], v14, s[36:39], s75 offen offset:1024 sc1
    buffer_store_dwordx4 v[36:39], v14, s[36:39], s75 offen offset:2048 sc1
    buffer_store_dwordx4 v[36:39], v14, s[36:39], s75 offen offset:3072 sc1
    s_lshl_b32 s70, s57, 2
    v_mov_b32 v52, 1
    s_waitcnt vmcnt(0)
    s_mov_b64 exec, 1
    buffer_atomic_add v52, off, s[40:43], s70 sc0
    s_mov_b64 exec, -1
    s_branch L_w5_wq
L_noreset:
L_wq3:
    buffer_load_ushort v57, v3, s[32:35], s74 offen offset:128
    buffer_load_ushort v58, v51, s[32:35], s74 offen offset:256
    buffer_load_dwordx4 v[172:175], v2, s[24:27], s62 offen offset:0 nt
    buffer_load_dwordx4 v[176:179], v2, s[24:27], s62 offen offset:128 nt
    s_waitcnt vmcnt(4)
    v_lshl_or_b32 v56, v56, 16, v56
    v_and_b32 v16, v56, v10
    v_and_b32 v17, v56, v11
    v_and_b32 v18, v56, v12
    v_and_b32 v19, v56, v13
    buffer_load_dwordx4 v[180:183], v2, s[24:27], s62 offen offset:256 nt
    buffer_load_dwordx4 v[184:187], v50, s[24:27], s63 offen offset:0 nt
    buffer_load_dwordx4 v[188:191], v50, s[24:27], s63 offen offset:128 nt
    s_nop 1
    v_mfma_f32_16x16x32_bf16 v[36:39], v[16:19], v[160:163], 0
    v_mfma_f32_16x16x32_bf16 v[40:43], v[16:19], v[164:167], 0
    v_mfma_f32_16x16x32_bf16 v[44:47], v[16:19], v[168:171], 0
    s_waitcnt vmcnt(6)
    v_lshl_or_b32 v57, v57, 16, v57
    v_and_b32 v20, v57, v10
    v_and_b32 v21, v57, v11
    v_and_b32 v22, v57, v12
    v_and_b32 v23, v57, v13
    s_nop 1
    s_waitcnt vmcnt(4)
    v_mfma_f32_16x16x32_bf16 v[36:39], v[20:23], v[172:175], v[36:39]
    buffer_load_dwordx4 v[192:195], v50, s[24:27], s63 offen offset:256 nt
    s_waitcnt vmcnt(4)
    v_mfma_f32_16x16x32_bf16 v[40:43], v[20:23], v[176:179], v[40:43]
    buffer_load_dwordx4 v[64:67], v1, s[16:19], 0 offen offset:0 nt
    s_waitcnt vmcnt(4)
    v_mfma_f32_16x16x32_bf16 v[44:47], v[20:23], v[180:183], v[44:47]
    buffer_load_dwordx4 v[68:71], v1, s[16:19], 0 offen offset:128 nt
    v_lshl_or_b32 v58, v58, 16, v58
    v_and_b32 v24, v58, v10
    v_and_b32 v25, v58, v11
    v_and_b32 v26, v58, v12
    v_and_b32 v27, v58, v13
    s_nop 1
    s_waitcnt vmcnt(4)
    v_mfma_f32_16x16x32_bf16 v[36:39], v[24:27], v[184:187], v[36:39]
    buffer_load_dwordx4 v[72:75], v1, s[16:19], 0 offen offset:256 nt
    s_waitcnt vmcnt(4)
    v_mfma_f32_16x16x32_bf16 v[40:43], v[24:27], v[188:191], v[40:43]
    buffer_load_dwordx4 v[76:79], v1, s[16:19], 0 offen offset:3072 nt
    s_waitcnt vmcnt(4)
    v_mfma_f32_16x16x32_bf16 v[44:47], v[24:27], v[192:195], v[44:47]
    buffer_load_dwordx4 v[80:83], v1, s[16:19], 0 offen offset:3200 nt
    v_mov_b32 v14, 0
    v_mov_b32 v15, 1
    s_mov_b32 exec_lo, 0x00ff00ff
    s_mov_b32 exec_hi, 0xff00ff00
    s_nop 3
    ds_write_b128 v7, v[36:39] offset:0
    ds_write_b128 v7, v[40:43] offset:256
    ds_write_b128 v7, v[44:47] offset:512
    s_mov_b64 exec, 1
    ds_add_u32 v14, v15 offset:12992
    s_mov_b64 exec, -1
L_wq_done:
    s_cmp_eq_u32 s58, 6
    s_cbranch_scc1 L_w6_x1
    s_waitcnt vmcnt(4)
    buffer_load_dwordx4 v[84:87], v1, s[16:19], 0 offen offset:3328 nt
    s_waitcnt vmcnt(4)
    buffer_load_dwordx4 v[88:91], v1, s[16:19], s59 offen offset:0 nt
    s_waitcnt vmcnt(4)
    buffer_load_dwordx4 v[92:95], v1, s[16:19], s59 offen offset:128 nt
    s_waitcnt vmcnt(4)
    buffer_load_dwordx4 v[96:99], v1, s[16:19], s59 offen offset:256 nt
    s_waitcnt vmcnt(4)
    buffer_load_dwordx4 v[100:103], v1, s[16:19], s59 offen offset:3072 nt
    s_waitcnt vmcnt(4)
    buffer_load_dwordx4 v[104:107], v1, s[16:19], s59 offen offset:3200 nt
    s_waitcnt vmcnt(4)
    buffer_load_dwordx4 v[108:111], v1, s[16:19], s59 offen offset:3328 nt
    s_waitcnt vmcnt(4)
    buffer_load_dwordx4 v[112:115], v1, s[16:19], s60 offen offset:0 nt
    s_waitcnt vmcnt(4)
    buffer_load_dwordx4 v[116:119], v1, s[16:19], s60 offen offset:128 nt
    s_waitcnt vmcnt(4)
    buffer_load_dwordx4 v[120:123], v1, s[16:19], s60 offen offset:256 nt
    s_waitcnt vmcnt(4)
    buffer_load_dwordx4 v[124:127], v1, s[16:19], s60 offen offset:3072 nt
    s_waitcnt vmcnt(4)
    buffer_load_dwordx4 v[128:131], v1, s[16:19], s60 offen offset:3200 nt
    s_waitcnt vmcnt(4)
    buffer_load_dwordx4 v[132:135], v1, s[16:19], s60 offen offset:3328 nt
    s_waitcnt vmcnt(4)
    buffer_load_dwordx4 v[136:139], v1, s[16:19], s61 offen offset:0 nt
    s_waitcnt vmcnt(4)
    buffer_load_dwordx4 v[140:143], v1, s[16:19], s61 offen offset:128 nt
    s_waitcnt vmcnt(4)
    buffer_load_dwordx4 v[144:147], v1, s[16:19], s61 offen offset:256 nt
    s_waitcnt vmcnt(4)
    buffer_load_dwordx4 v[148:151], v1, s[16:19], s61 offen offset:3072 nt
    s_waitcnt vmcnt(4)
    buffer_load_dwordx4 v[152:155], v1, s[16:19], s61 offen offset:3200 nt
    s_waitcnt vmcnt(4)
    buffer_load_dwordx4 v[156:159], v1, s[16:19], s61 offen offset:3328 nt
    s_waitcnt vmcnt(3)
    buffer_load_dwordx4 v[160:163], v1, s[20:23], 0 offen offset:0 nt
    s_waitcnt vmcnt(3)
    buffer_load_dwordx4 v[164:167], v1, s[20:23], 0 offen offset:128 nt
    s_waitcnt vmcnt(3)
    buffer_load_dwordx4 v[168:171], v1, s[20:23], 0 offen offset:256 nt
    s_waitcnt vmcnt(3)
    buffer_load_dwordx4 v[172:175], v1, s[20:23], 0 offen offset:3072 nt
    s_waitcnt vmcnt(3)
    buffer_load_dwordx4 v[176:179], v1, s[20:23], 0 offen offset:3200 nt
    s_waitcnt vmcnt(3)
    buffer_load_dwordx4 v[180:183], v1, s[20:23], 0 offen offset:3328 nt
    s_waitcnt vmcnt(3)
    buffer_load_dwordx4 v[184:187], v1, s[20:23], s59 offen offset:0 nt
    s_waitcnt vmcnt(3)
    buffer_load_dwordx4 v[188:191], v1, s[20:23], s59 offen offset:128 nt
    s_waitcnt vmcnt(3)
    buffer_load_dwordx4 v[192:195], v1, s[20:23], s59 offen offset:256 nt
    s_waitcnt vmcnt(3)
    buffer_load_dwordx4 v[196:199], v1, s[20:23], s59 offen offset:3072 nt
    s_waitcnt vmcnt(3)
    buffer_load_dwordx4 v[200:203], v1, s[20:23], s59 offen offset:3200 nt
    s_waitcnt vmcnt(3)
    buffer_load_dwordx4 v[204:207], v1, s[20:23], s59 offen offset:3328 nt
    s_waitcnt vmcnt(3)
    buffer_load_dwordx4 v[208:211], v1, s[20:23], s60 offen offset:0 nt
    s_branch L_b2
L_w5_wq:
L_wq5_3:
    buffer_load_ushort v57, v3, s[32:35], s74 offen offset:128
    buffer_load_ushort v58, v51, s[32:35], s74 offen offset:256
    buffer_load_dwordx4 v[172:175], v2, s[24:27], s62 offen offset:0 nt
    buffer_load_dwordx4 v[176:179], v2, s[24:27], s62 offen offset:128 nt
    buffer_load_dwordx4 v[180:183], v2, s[24:27], s62 offen offset:256 nt
    buffer_load_dwordx4 v[184:187], v50, s[24:27], s63 offen offset:0 nt
    buffer_load_dwordx4 v[188:191], v50, s[24:27], s63 offen offset:128 nt
    v_lshl_or_b32 v56, v56, 16, v56
    v_and_b32 v16, v56, v10
    v_and_b32 v17, v56, v11
    v_and_b32 v18, v56, v12
    v_and_b32 v19, v56, v13
    s_nop 1
    v_mfma_f32_16x16x32_bf16 v[36:39], v[16:19], v[160:163], 0
    v_mfma_f32_16x16x32_bf16 v[40:43], v[16:19], v[164:167], 0
    v_mfma_f32_16x16x32_bf16 v[44:47], v[16:19], v[168:171], 0
    s_waitcnt vmcnt(6)
    v_lshl_or_b32 v57, v57, 16, v57
    v_and_b32 v20, v57, v10
    v_and_b32 v21, v57, v11
    v_and_b32 v22, v57, v12
    v_and_b32 v23, v57, v13
    s_nop 1
    s_waitcnt vmcnt(4)
    v_mfma_f32_16x16x32_bf16 v[36:39], v[20:23], v[172:175], v[36:39]
    buffer_load_dwordx4 v[192:195], v50, s[24:27], s63 offen offset:256 nt
    buffer_load_dwordx4 v[64:67], v1, s[16:19], 0 offen offset:0 nt
    s_waitcnt vmcnt(5)
    v_mfma_f32_16x16x32_bf16 v[40:43], v[20:23], v[176:179], v[40:43]
    buffer_load_dwordx4 v[68:71], v1, s[16:19], 0 offen offset:128 nt
    s_waitcnt vmcnt(5)
    v_mfma_f32_16x16x32_bf16 v[44:47], v[20:23], v[180:183], v[44:47]
    buffer_load_dwordx4 v[72:75], v1, s[16:19], 0 offen offset:256 nt
    v_lshl_or_b32 v58, v58, 16, v58
    v_and_b32 v24, v58, v10
    v_and_b32 v25, v58, v11
    v_and_b32 v26, v58, v12
    v_and_b32 v27, v58, v13
    s_nop 1
    s_waitcnt vmcnt(5)
    v_mfma_f32_16x16x32_bf16 v[36:39], v[24:27], v[184:187], v[36:39]
    buffer_load_dwordx4 v[76:79], v1, s[16:19], 0 offen offset:3072 nt
    s_waitcnt vmcnt(5)
    v_mfma_f32_16x16x32_bf16 v[40:43], v[24:27], v[188:191], v[40:43]
    buffer_load_dwordx4 v[80:83], v1, s[16:19], 0 offen offset:3200 nt
    s_waitcnt vmcnt(5)
    v_mfma_f32_16x16x32_bf16 v[44:47], v[24:27], v[192:195], v[44:47]
    buffer_load_dwordx4 v[84:87], v1, s[16:19], 0 offen offset:3328 nt
    v_mov_b32 v14, 0
    v_mov_b32 v15, 1
    s_mov_b32 exec_lo, 0x00ff00ff
    s_mov_b32 exec_hi, 0xff00ff00
    s_nop 3
    ds_write_b128 v7, v[36:39] offset:0
    ds_write_b128 v7, v[40:43] offset:256
    ds_write_b128 v7, v[44:47] offset:512
    s_mov_b64 exec, 1
    ds_add_u32 v14, v15 offset:12992
    s_mov_b64 exec, -1
L_wq5__done:
    v_readfirstlane_b32 s69, v52
    s_mul_i32 s68, s57, 16384
    v_mul_u32_u24 v14, 4096, v0
    s_and_b32 s69, s69, 3
    s_cmp_lg_u32 s69, 3
    s_cbranch_scc1 L_w5_nogo
    s_mov_b64 exec, 15
    buffer_store_dword v15, v14, s[36:39], s68 offen offset:1008 sc1
    s_mov_b64 exec, -1
L_w5_nogo:
    v_mov_b32 v14, 0
    s_mov_b32 s67, 6400000
L_w5_rows:
    ds_read_b32 v15, v14 offset:12992
    s_sub_u32 s67, s67, 1
    s_cbranch_scc1 L_w5_rows_x
    s_waitcnt lgkmcnt(0)
    v_cmp_gt_u32 vcc, 8, v15
    s_cbranch_vccnz L_w5_rows
L_w5_rows_x:
    ds_read_b128 v[160:163], v8 offset:0
    ds_read_b128 v[164:167], v8 offset:768
    ds_read_b128 v[168:171], v8 offset:1536
    ds_read_b128 v[172:175], v8 offset:2304
    ds_read_b128 v[176:179], v8 offset:3072
    ds_read_b128 v[180:183], v8 offset:3840
    ds_read_b128 v[184:187], v8 offset:4608
    ds_read_b128 v[188:191], v8 offset:5376
    ds_read_b128 v[192:195], v8 offset:6144
    ds_read_b128 v[196:199], v8 offset:6912
    ds_read_b128 v[200:203], v8 offset:7680
    ds_read_b128 v[204:207], v8 offset:8448
    ds_read_b128 v[208:211], v8 offset:9216
    ds_read_b128 v[212:215], v8 offset:9984
    s_waitcnt lgkmcnt(12)
    v_pk_add_f32 v[160:161], v[160:161], v[164:165]
    v_pk_add_f32 v[162:163], v[162:163], v[166:167]
    ds_read_b128 v[216:219], v8 offset:10752
    ds_read_b128 v[220:223], v8 offset:11520
    s_waitcnt lgkmcnt(12)
    v_pk_add_f32 v[168:169], v[168:169], v[172:173]
    v_pk_add_f32 v[170:171], v[170:171], v[174:175]
    s_waitcnt lgkmcnt(10)
    v_pk_add_f32 v[176:177], v[176:177], v[180:181]
    v_pk_add_f32 v[178:179], v[178:179], v[182:183]
    s_waitcnt lgkmcnt(8)
    v_pk_add_f32 v[184:185], v[184:185], v[188:189]
    v_pk_add_f32 v[186:187], v[186:187], v[190:191]
    s_waitcnt lgkmcnt(6)
    v_pk_add_f32 v[192:193], v[192:193], v[196:197]
    v_pk_add_f32 v[194:195], v[194:195], v[198:199]
    s_waitcnt lgkmcnt(4)
    v_pk_add_f32 v[200:201], v[200:201], v[204:205]
    v_pk_add_f32 v[202:203], v[202:203], v[206:207]
    s_waitcnt lgkmcnt(2)
    v_pk_add_f32 v[208:209], v[208:209], v[212:213]
    v_pk_add_f32 v[210:211], v[210:211], v[214:215]
    s_waitcnt lgkmcnt(0)
    v_pk_add_f32 v[216:217], v[216:217], v[220:221]
    v_pk_add_f32 v[218:219], v[218:219], v[222:223]
    v_pk_add_f32 v[160:161], v[160:161], v[168:169]
    v_pk_add_f32 v[162:163], v[162:163], v[170:171]
    v_pk_add_f32 v[176:177], v[176:177], v[184:185]
    v_pk_add_f32 v[178:179], v[178:179], v[186:187]
    v_pk_add_f32 v[192:193], v[192:193], v[200:201]
    v_pk_add_f32 v[194:195], v[194:195], v[202:203]
    v_pk_add_f32 v[208:209], v[208:209], v[216:217]
    v_pk_add_f32 v[210:211], v[210:211], v[218:219]
    v_pk_add_f32 v[160:161], v[160:161], v[176:177]
    v_pk_add_f32 v[162:163], v[162:163], v[178:179]
    v_pk_add_f32 v[192:193], v[192:193], v[208:209]
    v_pk_add_f32 v[194:195], v[194:195], v[210:211]
    v_pk_add_f32 v[56:57], v[160:161], v[192:193]
    v_pk_add_f32 v[58:59], v[162:163], v[194:195]
    v_min_u32 v56, -2, v56
    v_min_u32 v57, -2, v57
    v_min_u32 v58, -2, v58
    v_min_u32 v59, -2, v59
    s_mov_b32 exec_lo, 0x0fff0fff
    s_mov_b32 exec_hi, 0x0fff0fff
    buffer_store_dwordx4 v[56:59], v8, s[36:39], s75 offen sc1
    s_mov_b64 exec, -1
    s_waitcnt vmcnt(5)
    buffer_load_dwordx4 v[88:91], v1, s[16:19], s59 offen offset:0 nt
    s_waitcnt vmcnt(5)
    buffer_load_dwordx4 v[92:95], v1, s[16:19], s59 offen offset:128 nt
    s_waitcnt vmcnt(5)
    buffer_load_dwordx4 v[96:99], v1, s[16:19], s59 offen offset:256 nt
    s_waitcnt vmcnt(5)
    buffer_load_dwordx4 v[100:103], v1, s[16:19], s59 offen offset:3072 nt
    s_waitcnt vmcnt(5)
    buffer_load_dwordx4 v[104:107], v1, s[16:19], s59 offen offset:3200 nt
    s_waitcnt vmcnt(5)
    buffer_load_dwordx4 v[108:111], v1, s[16:19], s59 offen offset:3328 nt
    s_waitcnt vmcnt(5)
    buffer_load_dwordx4 v[112:115], v1, s[16:19], s60 offen offset:0 nt
    s_waitcnt vmcnt(5)
    buffer_load_dwordx4 v[116:119], v1, s[16:19], s60 offen offset:128 nt
    s_waitcnt vmcnt(5)
    buffer_load_dwordx4 v[120:123], v1, s[16:19], s60 offen offset:256 nt
    s_waitcnt vmcnt(5)
    buffer_load_dwordx4 v[124:127], v1, s[16:19], s60 offen offset:3072 nt
    s_waitcnt vmcnt(5)
    buffer_load_dwordx4 v[128:131], v1, s[16:19], s60 offen offset:3200 nt
    s_waitcnt vmcnt(5)
    buffer_load_dwordx4 v[132:135], v1, s[16:19], s60 offen offset:3328 nt
    s_waitcnt vmcnt(5)
    buffer_load_dwordx4 v[136:139], v1, s[16:19], s61 offen offset:0 nt
    s_waitcnt vmcnt(5)
    buffer_load_dwordx4 v[140:143], v1, s[16:19], s61 offen offset:128 nt
    s_waitcnt vmcnt(5)
    buffer_load_dwordx4 v[144:147], v1, s[16:19], s61 offen offset:256 nt
    s_waitcnt vmcnt(5)
    buffer_load_dwordx4 v[148:151], v1, s[16:19], s61 offen offset:3072 nt
    s_waitcnt vmcnt(5)
    buffer_load_dwordx4 v[152:155], v1, s[16:19], s61 offen offset:3200 nt
    s_waitcnt vmcnt(5)
    buffer_load_dwordx4 v[156:159], v1, s[16:19], s61 offen offset:3328 nt
    s_waitcnt vmcnt(3)
    buffer_load_dwordx4 v[160:163], v1, s[20:23], 0 offen offset:0 nt
    s_waitcnt vmcnt(3)
    buffer_load_dwordx4 v[164:167], v1, s[20:23], 0 offen offset:128 nt
    s_waitcnt vmcnt(3)
    buffer_load_dwordx4 v[168:171], v1, s[20:23], 0 offen offset:256 nt
    s_waitcnt vmcnt(3)
    buffer_load_dwordx4 v[172:175], v1, s[20:23], 0 offen offset:3072 nt
    s_waitcnt vmcnt(3)
    buffer_load_dwordx4 v[176:179], v1, s[20:23], 0 offen offset:3200 nt
    s_waitcnt vmcnt(3)
    buffer_load_dwordx4 v[180:183], v1, s[20:23], 0 offen offset:3328 nt
    s_waitcnt vmcnt(3)
    buffer_load_dwordx4 v[184:187], v1, s[20:23], s59 offen offset:0 nt
    s_waitcnt vmcnt(3)
    buffer_load_dwordx4 v[188:191], v1, s[20:23], s59 offen offset:128 nt
    s_waitcnt vmcnt(3)
    buffer_load_dwordx4 v[192:195], v1, s[20:23], s59 offen offset:256 nt
    s_waitcnt vmcnt(3)
    buffer_load_dwordx4 v[196:199], v1, s[20:23], s59 offen offset:3072 nt
    s_waitcnt vmcnt(3)
    buffer_load_dwordx4 v[200:203], v1, s[20:23], s59 offen offset:3200 nt
    s_waitcnt vmcnt(3)
    buffer_load_dwordx4 v[204:207], v1, s[20:23], s59 offen offset:3328 nt
    s_waitcnt vmcnt(3)
    buffer_load_dwordx4 v[208:211], v1, s[20:23], s60 offen offset:0 nt
    s_cmp_lg_u32 s71, 5
    s_cbranch_scc1 L_b2
    s_lshl_b32 s68, s56, 7
    v_lshlrev_b32 v14, 2, v0
    v_and_b32 v14, 127, v14
    buffer_load_dword v63, v14, s[40:43], s68 offen sc1
    s_branch L_b2
L_w6_x1:
    s_mul_i32 s8, s57, 16384
    s_add_u32 s9, s8, 4096
    s_add_u32 s10, s8, 8192
    s_add_u32 s11, s8, 12288
    s_waitcnt vmcnt(4)
    buffer_load_dwordx4 v[84:87], v1, s[16:19], 0 offen offset:3328 nt
    s_waitcnt vmcnt(4)
    buffer_load_dwordx4 v[88:91], v1, s[16:19], s59 offen offset:0 nt
    s_waitcnt vmcnt(4)
    buffer_load_dwordx4 v[92:95], v1, s[16:19], s59 offen offset:128 nt
    s_waitcnt vmcnt(4)
    buffer_load_dwordx4 v[96:99], v1, s[16:19], s59 offen offset:256 nt
    s_waitcnt vmcnt(4)
    buffer_load_dwordx4 v[100:103], v1, s[16:19], s59 offen offset:3072 nt
    s_waitcnt vmcnt(4)
    buffer_load_dwordx4 v[104:107], v1, s[16:19], s59 offen offset:3200 nt
    s_waitcnt vmcnt(4)
    buffer_load_dwordx4 v[108:111], v1, s[16:19], s59 offen offset:3328 nt
    v_mov_b32 v14, 0
    s_mov_b32 s67, 6400000
L_w6_own_reset:
    ds_read_b32 v15, v14 offset:12992
    s_sub_u32 s67, s67, 1
    s_cbranch_scc1 L_w6_own_reset_x
    s_waitcnt lgkmcnt(0)
    v_cmp_gt_u32 vcc, 8, v15
    s_cbranch_vccnz L_w6_own_reset
L_w6_own_reset_x:
    buffer_load_dword v52, off, s[36:39], s75 offset:1008 sc1
    s_waitcnt vmcnt(5)
    buffer_load_dwordx4 v[112:115], v1, s[16:19], s60 offen offset:0 nt
    s_waitcnt vmcnt(5)
    buffer_load_dwordx4 v[116:119], v1, s[16:19], s60 offen offset:128 nt
    s_waitcnt vmcnt(5)
    buffer_load_dwordx4 v[120:123], v1, s[16:19], s60 offen offset:256 nt
    s_waitcnt vmcnt(5)
    buffer_load_dwordx4 v[124:127], v1, s[16:19], s60 offen offset:3072 nt
    s_waitcnt vmcnt(5)
    buffer_load_dwordx4 v[128:131], v1, s[16:19], s60 offen offset:3200 nt
    s_waitcnt vmcnt(5)
    s_mov_b32 s67, 400000
L_w6_go:
    v_cmp_eq_u32 vcc, -1, v52
    s_cbranch_vccz L_w6_go_ok
    buffer_load_dword v52, off, s[36:39], s75 offset:1008 sc1
    s_sub_u32 s67, s67, 1
    s_waitcnt vmcnt(0)
    s_cbranch_scc0 L_w6_go
L_w6_go_ok:
    v_lshrrev_b32 v14, 1, v8
    buffer_load_dwordx4 v[132:135], v1, s[16:19], s60 offen offset:3328 nt
    s_mov_b32 exec_lo, 0x0fff0fff
    s_mov_b32 exec_hi, 0x0fff0fff
    buffer_load_dwordx4 v[160:163], v8, s[36:39], s8 offen sc1
    buffer_load_dwordx4 v[164:167], v8, s[36:39], s9 offen sc1
    buffer_load_dwordx4 v[168:171], v8, s[36:39], s10 offen sc1
    buffer_load_dwordx4 v[172:175], v8, s[36:39], s11 offen sc1
    s_mov_b64 exec, -1
    s_waitcnt vmcnt(9)
    buffer_load_dwordx4 v[136:139], v1, s[16:19], s61 offen offset:0 nt
    s_waitcnt vmcnt(9)
    buffer_load_dwordx4 v[140:143], v1, s[16:19], s61 offen offset:128 nt
    s_waitcnt vmcnt(9)
    buffer_load_dwordx4 v[144:147], v1, s[16:19], s61 offen offset:256 nt
    s_waitcnt vmcnt(9)
    buffer_load_dwordx4 v[148:151], v1, s[16:19], s61 offen offset:3072 nt
    s_waitcnt vmcnt(9)
    buffer_load_dwordx4 v[152:155], v1, s[16:19], s61 offen offset:3200 nt
    s_waitcnt vmcnt(9)
    buffer_load_dwordx4 v[156:159], v1, s[16:19], s61 offen offset:3328 nt
    s_mov_b32 exec_lo, 0x0fff0fff
    s_mov_b32 exec_hi, 0x0fff0fff
    s_mov_b32 s67, 400000
    s_waitcnt vmcnt(6)
L_w6_q:
    v_max3_u32 v15, v160, v161, v162
    v_max3_u32 v15, v15, v163, v164
    v_max3_u32 v15, v15, v165, v166
    v_max3_u32 v15, v15, v167, v168
    v_max3_u32 v15, v15, v169, v170
    v_max3_u32 v15, v15, v171, v172
    v_max3_u32 v15, v15, v173, v174
    v_max_u32 v15, v15, v175
    v_cmp_eq_u32 vcc, -1, v15
    s_cbranch_vccz L_w6_q_ok
    s_mov_b64 exec, vcc
    buffer_load_dwordx4 v[160:163], v8, s[36:39], s8 offen sc1
    buffer_load_dwordx4 v[164:167], v8, s[36:39], s9 offen sc1
    buffer_load_dwordx4 v[168:171], v8, s[36:39], s10 offen sc1
    buffer_load_dwordx4 v[172:175], v8, s[36:39], s11 offen sc1
    s_sub_u32 s67, s67, 1
    s_waitcnt vmcnt(0)
    s_cbranch_scc0 L_w6_q
L_w6_q_ok:
    s_mov_b32 exec_lo, 0x0fff0fff
    s_mov_b32 exec_hi, 0x0fff0fff
    v_pk_add_f32 v[160:161], v[160:161], v[164:165]
    v_pk_add_f32 v[168:169], v[168:169], v[172:173]
    v_pk_add_f32 v[162:163], v[162:163], v[166:167]
    v_pk_add_f32 v[170:171], v[170:171], v[174:175]
    v_pk_add_f32 v[160:161], v[160:161], v[168:169]
    v_pk_add_f32 v[162:163], v[162:163], v[170:171]
    v_cvt_pk_bf16_f32 v60, v160, v161
    v_cvt_pk_bf16_f32 v61, v162, v163
    ds_write_b64 v14, v[60:61] offset:12288
    s_mov_b64 exec, -1
    v_mov_b32 v14, 0
    v_mov_b32 v15, 1
    ds_write_b32 v14, v15 offset:12996
    s_waitcnt vmcnt(3)
    buffer_load_dwordx4 v[160:163], v1, s[20:23], 0 offen offset:0 nt
    s_waitcnt vmcnt(3)
    buffer_load_dwordx4 v[164:167], v1, s[20:23], 0 offen offset:128 nt
    s_waitcnt vmcnt(3)
    buffer_load_dwordx4 v[168:171], v1, s[20:23], 0 offen offset:256 nt
    s_waitcnt vmcnt(3)
    buffer_load_dwordx4 v[172:175], v1, s[20:23], 0 offen offset:3072 nt
    s_waitcnt vmcnt(3)
    buffer_load_dwordx4 v[176:179], v1, s[20:23], 0 offen offset:3200 nt
    s_waitcnt vmcnt(3)
    buffer_load_dwordx4 v[180:183], v1, s[20:23], 0 offen offset:3328 nt
    s_waitcnt vmcnt(3)
    buffer_load_dwordx4 v[184:187], v1, s[20:23], s59 offen offset:0 nt
    s_waitcnt vmcnt(3)
    buffer_load_dwordx4 v[188:191], v1, s[20:23], s59 offen offset:128 nt
    s_waitcnt vmcnt(3)
    buffer_load_dwordx4 v[192:195], v1, s[20:23], s59 offen offset:256 nt
    s_waitcnt vmcnt(3)
    buffer_load_dwordx4 v[196:199], v1, s[20:23], s59 offen offset:3072 nt
    s_waitcnt vmcnt(3)
    buffer_load_dwordx4 v[200:203], v1, s[20:23], s59 offen offset:3200 nt
    s_waitcnt vmcnt(3)
    buffer_load_dwordx4 v[204:207], v1, s[20:23], s59 offen offset:3328 nt
    s_waitcnt vmcnt(3)
    buffer_load_dwordx4 v[208:211], v1, s[20:23], s60 offen offset:0 nt
L_b2:
    v_mov_b32 v28, 0
    v_mov_b32 v29, 0
    v_mov_b32 v30, 0
    v_mov_b32 v31, 0
    v_mov_b32 v32, 0
    v_mov_b32 v33, 0
    v_mov_b32 v34, 0
    v_mov_b32 v35, 0
    v_mov_b32 v14, 0
    s_mov_b32 s67, 6400000
L_qwait:
    ds_read_b32 v15, v14 offset:12996
    ds_read_b128 v[16:19], v9 offset:12288
    ds_read_b128 v[20:23], v9 offset:12416
    ds_read_b128 v[24:27], v9 offset:12544
    s_sub_u32 s67, s67, 1
    s_cbranch_scc1 L_qwait_x
    s_waitcnt lgkmcnt(0)
    v_cmp_gt_u32 vcc, 1, v15
    s_cbranch_vccnz L_qwait
L_qwait_x:
    s_waitcnt vmcnt(13)
    v_dot2c_f32_bf16 v28, v64, v16
    v_dot2c_f32_bf16 v29, v76, v16
    v_dot2c_f32_bf16 v30, v88, v16
    v_dot2c_f32_bf16 v31, v100, v16
    v_dot2c_f32_bf16 v32, v112, v16
    v_dot2c_f32_bf16 v33, v124, v16
    v_dot2c_f32_bf16 v34, v136, v16
    v_dot2c_f32_bf16 v35, v148, v16
    v_dot2c_f32_bf16 v28, v65, v17
    v_dot2c_f32_bf16 v29, v77, v17
    v_dot2c_f32_bf16 v30, v89, v17
    v_dot2c_f32_bf16 v31, v101, v17
    v_dot2c_f32_bf16 v32, v113, v17
    v_dot2c_f32_bf16 v33, v125, v17
    v_dot2c_f32_bf16 v34, v137, v17
    v_dot2c_f32_bf16 v35, v149, v17
    v_dot2c_f32_bf16 v28, v66, v18
    v_dot2c_f32_bf16 v29, v78, v18
    v_dot2c_f32_bf16 v30, v90, v18
    v_dot2c_f32_bf16 v31, v102, v18
    v_dot2c_f32_bf16 v32, v114, v18
    v_dot2c_f32_bf16 v33, v126, v18
    v_dot2c_f32_bf16 v34, v138, v18
    v_dot2c_f32_bf16 v35, v150, v18
    v_dot2c_f32_bf16 v28, v67, v19
    v_dot2c_f32_bf16 v29, v79, v19
    v_dot2c_f32_bf16 v30, v91, v19
    v_dot2c_f32_bf16 v31, v103, v19
    v_dot2c_f32_bf16 v32, v115, v19
    v_dot2c_f32_bf16 v33, v127, v19
    v_dot2c_f32_bf16 v34, v139, v19
    v_dot2c_f32_bf16 v35, v151, v19
    s_waitcnt vmcnt(2)
    buffer_load_dwordx4 v[212:215], v1, s[20:23], s60 offen offset:128 nt
    v_dot2c_f32_bf16 v28, v68, v20
    v_dot2c_f32_bf16 v29, v80, v20
    v_dot2c_f32_bf16 v30, v92, v20
    v_dot2c_f32_bf16 v31, v104, v20
    v_dot2c_f32_bf16 v32, v116, v20
    v_dot2c_f32_bf16 v33, v128, v20
    v_dot2c_f32_bf16 v34, v140, v20
    v_dot2c_f32_bf16 v35, v152, v20
    v_dot2c_f32_bf16 v28, v69, v21
    v_dot2c_f32_bf16 v29, v81, v21
    v_dot2c_f32_bf16 v30, v93, v21
    v_dot2c_f32_bf16 v31, v105, v21
    v_dot2c_f32_bf16 v32, v117, v21
    v_dot2c_f32_bf16 v33, v129, v21
    v_dot2c_f32_bf16 v34, v141, v21
    v_dot2c_f32_bf16 v35, v153, v21
    v_dot2c_f32_bf16 v28, v70, v22
    v_dot2c_f32_bf16 v29, v82, v22
    v_dot2c_f32_bf16 v30, v94, v22
    v_dot2c_f32_bf16 v31, v106, v22
    v_dot2c_f32_bf16 v32, v118, v22
    v_dot2c_f32_bf16 v33, v130, v22
    v_dot2c_f32_bf16 v34, v142, v22
    v_dot2c_f32_bf16 v35, v154, v22
    v_dot2c_f32_bf16 v28, v71, v23
    v_dot2c_f32_bf16 v29, v83, v23
    v_dot2c_f32_bf16 v30, v95, v23
    v_dot2c_f32_bf16 v31, v107, v23
    v_dot2c_f32_bf16 v32, v119, v23
    v_dot2c_f32_bf16 v33, v131, v23
    v_dot2c_f32_bf16 v34, v143, v23
    v_dot2c_f32_bf16 v35, v155, v23
    s_waitcnt vmcnt(2)
    buffer_load_dwordx4 v[216:219], v1, s[20:23], s60 offen offset:256 nt
    v_dot2c_f32_bf16 v28, v72, v24
    v_dot2c_f32_bf16 v29, v84, v24
    v_dot2c_f32_bf16 v30, v96, v24
    v_dot2c_f32_bf16 v31, v108, v24
    v_dot2c_f32_bf16 v32, v120, v24
    v_dot2c_f32_bf16 v33, v132, v24
    v_dot2c_f32_bf16 v34, v144, v24
    v_dot2c_f32_bf16 v35, v156, v24
    v_dot2c_f32_bf16 v28, v73, v25
    v_dot2c_f32_bf16 v29, v85, v25
    v_dot2c_f32_bf16 v30, v97, v25
    v_dot2c_f32_bf16 v31, v109, v25
    v_dot2c_f32_bf16 v32, v121, v25
    v_dot2c_f32_bf16 v33, v133, v25
    v_dot2c_f32_bf16 v34, v145, v25
    v_dot2c_f32_bf16 v35, v157, v25
    v_dot2c_f32_bf16 v28, v74, v26
    v_dot2c_f32_bf16 v29, v86, v26
    v_dot2c_f32_bf16 v30, v98, v26
    v_dot2c_f32_bf16 v31, v110, v26
    v_dot2c_f32_bf16 v32, v122, v26
    v_dot2c_f32_bf16 v33, v134, v26
    v_dot2c_f32_bf16 v34, v146, v26
    v_dot2c_f32_bf16 v35, v158, v26
    v_dot2c_f32_bf16 v28, v75, v27
    v_dot2c_f32_bf16 v29, v87, v27
    v_dot2c_f32_bf16 v30, v99, v27
    v_dot2c_f32_bf16 v31, v111, v27
    v_dot2c_f32_bf16 v32, v123, v27
    v_dot2c_f32_bf16 v33, v135, v27
    v_dot2c_f32_bf16 v34, v147, v27
    v_dot2c_f32_bf16 v35, v159, v27
    s_waitcnt vmcnt(2)
    buffer_load_dwordx4 v[220:223], v1, s[20:23], s60 offen offset:3072 nt
    v_add_f32_dpp v28, v28, v28 quad_perm:[1,0,3,2] row_mask:0xf bank_mask:0xf
    v_add_f32_dpp v29, v29, v29 quad_perm:[1,0,3,2] row_mask:0xf bank_mask:0xf
    v_add_f32_dpp v30, v30, v30 quad_perm:[1,0,3,2] row_mask:0xf bank_mask:0xf
    v_add_f32_dpp v31, v31, v31 quad_perm:[1,0,3,2] row_mask:0xf bank_mask:0xf
    v_add_f32_dpp v32, v32, v32 quad_perm:[1,0,3,2] row_mask:0xf bank_mask:0xf
    v_add_f32_dpp v33, v33, v33 quad_perm:[1,0,3,2] row_mask:0xf bank_mask:0xf
    v_add_f32_dpp v34, v34, v34 quad_perm:[1,0,3,2] row_mask:0xf bank_mask:0xf
    v_add_f32_dpp v35, v35, v35 quad_perm:[1,0,3,2] row_mask:0xf bank_mask:0xf
    v_add_f32_dpp v28, v28, v28 quad_perm:[2,3,0,1] row_mask:0xf bank_mask:0xf
    v_add_f32_dpp v29, v29, v29 quad_perm:[2,3,0,1] row_mask:0xf bank_mask:0xf
    v_add_f32_dpp v30, v30, v30 quad_perm:[2,3,0,1] row_mask:0xf bank_mask:0xf
    v_add_f32_dpp v31, v31, v31 quad_perm:[2,3,0,1] row_mask:0xf bank_mask:0xf
    v_add_f32_dpp v32, v32, v32 quad_perm:[2,3,0,1] row_mask:0xf bank_mask:0xf
    v_add_f32_dpp v33, v33, v33 quad_perm:[2,3,0,1] row_mask:0xf bank_mask:0xf
    v_add_f32_dpp v34, v34, v34 quad_perm:[2,3,0,1] row_mask:0xf bank_mask:0xf
    v_add_f32_dpp v35, v35, v35 quad_perm:[2,3,0,1] row_mask:0xf bank_mask:0xf
    v_add_f32_dpp v28, v28, v28 row_half_mirror row_mask:0xf bank_mask:0xf
    v_add_f32_dpp v29, v29, v29 row_half_mirror row_mask:0xf bank_mask:0xf
    v_add_f32_dpp v30, v30, v30 row_half_mirror row_mask:0xf bank_mask:0xf
    v_add_f32_dpp v31, v31, v31 row_half_mirror row_mask:0xf bank_mask:0xf
    v_add_f32_dpp v32, v32, v32 row_half_mirror row_mask:0xf bank_mask:0xf
    v_add_f32_dpp v33, v33, v33 row_half_mirror row_mask:0xf bank_mask:0xf
    v_add_f32_dpp v34, v34, v34 row_half_mirror row_mask:0xf bank_mask:0xf
    v_add_f32_dpp v35, v35, v35 row_half_mirror row_mask:0xf bank_mask:0xf
    v_cvt_pk_bf16_f32 v28, 0, v28
    v_cvt_pk_bf16_f32 v29, 0, v29
    v_cvt_pk_bf16_f32 v30, 0, v30
    v_cvt_pk_bf16_f32 v31, 0, v31
    v_cvt_pk_bf16_f32 v32, 0, v32
    v_cvt_pk_bf16_f32 v33, 0, v33
    v_cvt_pk_bf16_f32 v34, 0, v34
    v_cvt_pk_bf16_f32 v35, 0, v35
    v_mul_f32 v28, 0x3d93cd3a, v28
    v_mul_f32 v29, 0x3d93cd3a, v29
    v_mul_f32 v30, 0x3d93cd3a, v30
    v_mul_f32 v31, 0x3d93cd3a, v31
    v_mul_f32 v32, 0x3d93cd3a, v32
    v_mul_f32 v33, 0x3d93cd3a, v33
    v_mul_f32 v34, 0x3d93cd3a, v34
    v_mul_f32 v35, 0x3d93cd3a, v35
    v_cvt_pk_bf16_f32 v28, 0, v28
    v_cvt_pk_bf16_f32 v29, 0, v29
    v_cvt_pk_bf16_f32 v30, 0, v30
    v_cvt_pk_bf16_f32 v31, 0, v31
    v_cvt_pk_bf16_f32 v32, 0, v32
    v_cvt_pk_bf16_f32 v33, 0, v33
    v_cvt_pk_bf16_f32 v34, 0, v34
    v_cvt_pk_bf16_f32 v35, 0, v35
    v_max3_f32 v14, v28, v29, v30
    v_max3_f32 v15, v31, v32, v33
    v_max3_f32 v14, v14, v34, v35
    v_max_f32 v14, v14, v15
    s_lshl_b32 s68, s58, 2
    v_mov_b32 v48, s68
    v_max_f32_dpp v14, v14, v14 row_ror:8 row_mask:0xf bank_mask:0xf
    s_nop 1
    v_max_f32_dpp v14, v14, v14 row_bcast:15 row_mask:0xa bank_mask:0xf
    s_nop 1
    v_max_f32_dpp v14, v14, v14 row_bcast:31 row_mask:0xc bank_mask:0xf
    s_nop 0
    v_readlane_b32 s68, v14, 63
    v_mov_b32 v62, s66
    s_nop 0
    v_mul_f32 v62, s68, v62
    ds_write_b32 v48, v62 offset:12800
    v_fma_f32 v28, v28, s66, -v62
    v_fma_f32 v29, v29, s66, -v62
    v_fma_f32 v30, v30, s66, -v62
    v_fma_f32 v31, v31, s66, -v62
    v_fma_f32 v32, v32, s66, -v62
    v_fma_f32 v33, v33, s66, -v62
    v_fma_f32 v34, v34, s66, -v62
    v_fma_f32 v35, v35, s66, -v62
    v_exp_f32 v28, v28
    v_exp_f32 v29, v29
    v_exp_f32 v30, v30
    v_exp_f32 v31, v31
    v_exp_f32 v32, v32
    v_exp_f32 v33, v33
    v_exp_f32 v34, v34
    v_exp_f32 v35, v35
    s_waitcnt vmcnt(2)
    buffer_load_dwordx4 v[224:227], v1, s[20:23], s60 offen offset:3200 nt
    s_nop 0
    v_cvt_pk_bf16_f32 v52, v28, v28
    v_cvt_pk_bf16_f32 v53, v29, v29
    v_cvt_pk_bf16_f32 v54, v30, v30
    v_cvt_pk_bf16_f32 v55, v31, v31
    v_cvt_pk_bf16_f32 v56, v32, v32
    v_cvt_pk_bf16_f32 v57, v33, v33
    v_cvt_pk_bf16_f32 v58, v34, v34
    v_cvt_pk_bf16_f32 v59, v35, v35
    v_and_b32 v64, v52, v10
    v_and_b32 v65, v52, v11
    v_and_b32 v66, v52, v12
    v_and_b32 v67, v52, v13
    v_and_b32 v68, v53, v10
    v_and_b32 v69, v53, v11
    v_and_b32 v70, v53, v12
    v_and_b32 v71, v53, v13
    v_and_b32 v72, v54, v10
    v_and_b32 v73, v54, v11
    v_and_b32 v74, v54, v12
    v_and_b32 v75, v54, v13
    v_and_b32 v76, v55, v10
    v_and_b32 v77, v55, v11
    v_and_b32 v78, v55, v12
    v_and_b32 v79, v55, v13
    v_and_b32 v80, v56, v10
    v_and_b32 v81, v56, v11
    v_and_b32 v82, v56, v12
    v_and_b32 v83, v56, v13
    v_and_b32 v84, v57, v10
    v_and_b32 v85, v57, v11
    v_and_b32 v86, v57, v12
    v_and_b32 v87, v57, v13
    v_and_b32 v88, v58, v10
    v_and_b32 v89, v58, v11
    v_and_b32 v90, v58, v12
    v_and_b32 v91, v58, v13
    v_and_b32 v92, v59, v10
    v_and_b32 v93, v59, v11
    v_and_b32 v94, v59, v12
    v_and_b32 v95, v59, v13
    v_add_f32 v28, v28, v29
    v_add_f32 v30, v30, v31
    v_add_f32 v32, v32, v33
    v_add_f32 v34, v34, v35
    v_add_f32 v28, v28, v30
    v_add_f32 v32, v32, v34
    v_add_f32 v28, v28, v32
    s_nop 1
    v_add_f32_dpp v28, v28, v28 row_ror:8 row_mask:0xf bank_mask:0xf
    s_nop 1
    v_add_f32_dpp v28, v28, v28 row_bcast:15 row_mask:0xa bank_mask:0xf
    s_nop 1
    v_add_f32_dpp v28, v28, v28 row_bcast:31 row_mask:0xc bank_mask:0xf
    s_mov_b32 exec_lo, 0
    s_mov_b32 exec_hi, 0x80000000
    ds_write_b32 v48, v28 offset:12832
    s_mov_b64 exec, -1
    v_mov_b32 v14, 0x0c0c0c0c
    v_mov_b32 v15, 0x01000100
    v_mov_b32 v52, 0x03020302
    v_bfi_b32 v16, v10, v15, v14
    v_bfi_b32 v20, v10, v52, v14
    v_bfi_b32 v17, v11, v15, v14
    v_bfi_b32 v21, v11, v52, v14
    v_bfi_b32 v18, v12, v15, v14
    v_bfi_b32 v22, v12, v52, v14
    v_bfi_b32 v19, v13, v15, v14
    v_bfi_b32 v23, v13, v52, v14
    s_cmp_lg_u32 s71, 5
    s_cbranch_scc1 L_chk_ok
    s_lshl_b32 s68, s56, 7
    v_lshlrev_b32 v14, 2, v0
    v_and_b32 v14, 127, v14
    s_waitcnt vmcnt(3)
    s_mov_b32 s67, 400000
L_chk:
    v_cmp_gt_u32 vcc, 4, v63
    s_cbranch_vccz L_chk_ok
    s_sleep 16
    buffer_load_dword v63, v14, s[40:43], s68 offen sc1
    s_sub_u32 s67, s67, 1
    s_waitcnt vmcnt(0)
    s_cbranch_scc0 L_chk
L_chk_ok:
    v_mfma_f32_16x16x32_bf16 v[36:39], v[64:67], v[160:163], 0
    v_mfma_f32_16x16x32_bf16 v[40:43], v[64:67], v[164:167], 0
    v_mfma_f32_16x16x32_bf16 v[44:47], v[64:67], v[168:171], 0
    v_mfma_f32_16x16x32_bf16 v[36:39], v[68:71], v[172:175], v[36:39]
    v_mfma_f32_16x16x32_bf16 v[40:43], v[68:71], v[176:179], v[40:43]
    v_mfma_f32_16x16x32_bf16 v[44:47], v[68:71], v[180:183], v[44:47]
    v_mfma_f32_16x16x32_bf16 v[36:39], v[72:75], v[184:187], v[36:39]
    v_mfma_f32_16x16x32_bf16 v[40:43], v[72:75], v[188:191], v[40:43]
    v_mfma_f32_16x16x32_bf16 v[44:47], v[72:75], v[192:195], v[44:47]
    v_mfma_f32_16x16x32_bf16 v[36:39], v[76:79], v[196:199], v[36:39]
    v_mfma_f32_16x16x32_bf16 v[40:43], v[76:79], v[200:203], v[40:43]
    v_mfma_f32_16x16x32_bf16 v[44:47], v[76:79], v[204:207], v[44:47]
    v_mfma_f32_16x16x32_bf16 v[36:39], v[80:83], v[208:211], v[36:39]
    v_mfma_f32_16x16x32_bf16 v[40:43], v[80:83], v[212:215], v[40:43]
    s_waitcnt vmcnt(2)
    v_mfma_f32_16x16x32_bf16 v[44:47], v[80:83], v[216:219], v[44:47]
    buffer_load_dwordx4 v[228:231], v1, s[20:23], s60 offen offset:3328 nt
    s_waitcnt vmcnt(2)
    v_mfma_f32_16x16x32_bf16 v[36:39], v[84:87], v[220:223], v[36:39]
    buffer_load_dwordx4 v[232:235], v1, s[20:23], s61 offen offset:0 nt
    s_waitcnt vmcnt(2)
    v_mfma_f32_16x16x32_bf16 v[40:43], v[84:87], v[224:227], v[40:43]
    buffer_load_dwordx4 v[236:239], v1, s[20:23], s61 offen offset:128 nt
    s_waitcnt vmcnt(2)
    v_mfma_f32_16x16x32_bf16 v[44:47], v[84:87], v[228:231], v[44:47]
    buffer_load_dwordx4 v[240:243], v1, s[20:23], s61 offen offset:256 nt
    s_waitcnt vmcnt(2)
    v_mfma_f32_16x16x32_bf16 v[36:39], v[88:91], v[232:235], v[36:39]
    buffer_load_dwordx4 v[244:247], v1, s[20:23], s61 offen offset:3072 nt
    s_waitcnt vmcnt(2)
    v_mfma_f32_16x16x32_bf16 v[40:43], v[88:91], v[236:239], v[40:43]
    buffer_load_dwordx4 v[248:251], v1, s[20:23], s61 offen offset:3200 nt
    s_waitcnt vmcnt(2)
    v_mfma_f32_16x16x32_bf16 v[44:47], v[88:91], v[240:243], v[44:47]
    buffer_load_dwordx4 v[252:255], v1, s[20:23], s61 offen offset:3328 nt
    s_waitcnt lgkmcnt(0)
    s_barrier
    s_cmp_ge_u32 s58, 4
    s_cbranch_scc1 L_roleB
    s_cmp_eq_u32 s58, 0
    s_cbranch_scc1 L_role0
    s_waitcnt vmcnt(2)
    v_mfma_f32_16x16x32_bf16 v[36:39], v[92:95], v[244:247], v[36:39]
    buffer_load_dwordx4 v[96:99], v6, s[28:31], 0 offen offset:0 nt
    s_waitcnt vmcnt(2)
    v_mfma_f32_16x16x32_bf16 v[40:43], v[92:95], v[248:251], v[40:43]
    buffer_load_dwordx4 v[100:103], v6, s[28:31], 0 offen offset:1280 nt
    s_waitcnt vmcnt(2)
    v_mfma_f32_16x16x32_bf16 v[44:47], v[92:95], v[252:255], v[44:47]
    buffer_load_dwordx4 v[104:107], v6, s[28:31], 0 offen offset:2560 nt
    v_mov_b32 v14, 0
    v_mov_b32 v15, 1
    s_mov_b32 exec_lo, 0x00ff00ff
    s_mov_b32 exec_hi, 0xff00ff00
    s_nop 3
    ds_write_b128 v7, v[36:39] offset:0
    ds_write_b128 v7, v[40:43] offset:256
    ds_write_b128 v7, v[44:47] offset:512
    s_mov_b64 exec, 1
    ds_add_u32 v14, v15 offset:13000
    s_mov_b64 exec, -1
    buffer_load_dwordx4 v[108:111], v6, s[28:31], 0 offen offset:3840 nt
    s_waitcnt vmcnt(3)
    buffer_load_dwordx4 v[112:115], v6, s[28:31], s64 offen offset:0 nt
    s_waitcnt vmcnt(3)
    buffer_load_dwordx4 v[116:119], v6, s[28:31], s64 offen offset:1280 nt
    s_waitcnt vmcnt(3)
    buffer_load_dwordx4 v[120:123], v6, s[28:31], s64 offen offset:2560 nt
    s_waitcnt vmcnt(3)
    buffer_load_dwordx4 v[124:127], v6, s[28:31], s64 offen offset:3840 nt
    s_waitcnt vmcnt(3)
    buffer_load_dwordx4 v[128:131], v6, s[28:31], s65 offen offset:0 nt
    s_waitcnt vmcnt(3)
    buffer_load_dwordx4 v[132:135], v6, s[28:31], s65 offen offset:1280 nt
    s_waitcnt vmcnt(3)
    buffer_load_dwordx4 v[136:139], v6, s[28:31], s65 offen offset:2560 nt
    s_waitcnt vmcnt(3)
    buffer_load_dwordx4 v[140:143], v6, s[28:31], s65 offen offset:3840 nt
    s_mov_b32 s67, 6400000
L_owait1:
    ds_read_b128 v[52:55], v5 offset:12880
    ds_read_b128 v[48:51], v5 offset:12864
    s_sub_u32 s67, s67, 1
    s_cbranch_scc1 L_owait1_x
    s_waitcnt lgkmcnt(0)
    v_cmp_eq_u32 vcc, 0, v54
    s_cbranch_vccnz L_owait1
L_owait1_x:
    v_perm_b32 v208, v48, v48, v16
    v_perm_b32 v209, v48, v48, v17
    v_perm_b32 v210, v48, v48, v18
    v_perm_b32 v211, v48, v48, v19
    v_perm_b32 v212, v48, v48, v20
    v_perm_b32 v213, v48, v48, v21
    v_perm_b32 v214, v48, v48, v22
    v_perm_b32 v215, v48, v48, v23
    v_mfma_f32_16x16x32_bf16 v[36:39], v[208:211], v[96:99], 0
    v_perm_b32 v216, v49, v49, v16
    v_perm_b32 v217, v49, v49, v17
    v_perm_b32 v218, v49, v49, v18
    v_perm_b32 v219, v49, v49, v19
    v_mfma_f32_16x16x32_bf16 v[36:39], v[212:215], v[100:103], v[36:39]
    v_perm_b32 v220, v49, v49, v20
    v_perm_b32 v221, v49, v49, v21
    v_perm_b32 v222, v49, v49, v22
    v_perm_b32 v223, v49, v49, v23
    v_mfma_f32_16x16x32_bf16 v[36:39], v[216:219], v[104:107], v[36:39]
    v_perm_b32 v208, v50, v50, v16
    v_perm_b32 v209, v50, v50, v17
    v_perm_b32 v210, v50, v50, v18
    v_perm_b32 v211, v50, v50, v19
    v_mfma_f32_16x16x32_bf16 v[36:39], v[220:223], v[108:111], v[36:39]
    v_perm_b32 v212, v50, v50, v20
    v_perm_b32 v213, v50, v50, v21
    v_perm_b32 v214, v50, v50, v22
    v_perm_b32 v215, v50, v50, v23
    v_mfma_f32_16x16x32_bf16 v[36:39], v[208:211], v[112:115], v[36:39]
    v_perm_b32 v216, v51, v51, v16
    v_perm_b32 v217, v51, v51, v17
    v_perm_b32 v218, v51, v51, v18
    v_perm_b32 v219, v51, v51, v19
    v_mfma_f32_16x16x32_bf16 v[36:39], v[212:215], v[116:119], v[36:39]
    v_perm_b32 v220, v51, v51, v20
    v_perm_b32 v221, v51, v51, v21
    v_perm_b32 v222, v51, v51, v22
    v_perm_b32 v223, v51, v51, v23
    v_mfma_f32_16x16x32_bf16 v[36:39], v[216:219], v[120:123], v[36:39]
    v_perm_b32 v208, v52, v52, v16
    v_perm_b32 v209, v52, v52, v17
    v_perm_b32 v210, v52, v52, v18
    v_perm_b32 v211, v52, v52, v19
    v_mfma_f32_16x16x32_bf16 v[36:39], v[220:223], v[124:127], v[36:39]
    v_perm_b32 v212, v52, v52, v20
    v_perm_b32 v213, v52, v52, v21
    v_perm_b32 v214, v52, v52, v22
    v_perm_b32 v215, v52, v52, v23
    s_waitcnt vmcnt(3)
    v_mfma_f32_16x16x32_bf16 v[36:39], v[208:211], v[128:131], v[36:39]
    v_perm_b32 v216, v53, v53, v16
    v_perm_b32 v217, v53, v53, v17
    v_perm_b32 v218, v53, v53, v18
    v_perm_b32 v219, v53, v53, v19
    s_waitcnt vmcnt(2)
    v_mfma_f32_16x16x32_bf16 v[36:39], v[212:215], v[132:135], v[36:39]
    v_perm_b32 v220, v53, v53, v20
    v_perm_b32 v221, v53, v53, v21
    v_perm_b32 v222, v53, v53, v22
    v_perm_b32 v223, v53, v53, v23
    s_waitcnt vmcnt(1)
    v_mfma_f32_16x16x32_bf16 v[36:39], v[216:219], v[136:139], v[36:39]
    s_nop 0
    s_waitcnt vmcnt(0)
    v_mfma_f32_16x16x32_bf16 v[36:39], v[220:223], v[140:143], v[36:39]
    s_mov_b32 exec_hi, 0
    s_nop 6
    v_min_u32 v36, -2, v36
    v_min_u32 v37, -2, v37
    v_min_u32 v38, -2, v38
    v_min_u32 v39, -2, v39
    buffer_store_dwordx4 v[36:39], v4, s[36:39], s75 offen offset:1536 sc1
    s_mov_b32 exec_hi, -1
    s_branch L_final
L_role0:
    v_add_u32 v61, 1024, v6
    buffer_load_dwordx4 v[96:99], v6, s[28:31], 0 offen offset:0 nt
    buffer_load_dwordx4 v[160:163], v61, s[28:31], 0 offen offset:0 nt
    buffer_load_dwordx4 v[100:103], v6, s[28:31], 0 offen offset:1280 nt
    s_waitcnt vmcnt(5)
    v_mfma_f32_16x16x32_bf16 v[36:39], v[92:95], v[244:247], v[36:39]
    buffer_load_dwordx4 v[164:167], v61, s[28:31], 0 offen offset:1280 nt
    s_waitcnt vmcnt(5)
    v_mfma_f32_16x16x32_bf16 v[40:43], v[92:95], v[248:251], v[40:43]
    buffer_load_dwordx4 v[104:107], v6, s[28:31], 0 offen offset:2560 nt
    s_waitcnt vmcnt(5)
    v_mfma_f32_16x16x32_bf16 v[44:47], v[92:95], v[252:255], v[44:47]
    buffer_load_dwordx4 v[168:171], v61, s[28:31], 0 offen offset:2560 nt
    v_mov_b32 v14, 0
    v_mov_b32 v15, 1
    s_mov_b32 exec_lo, 0x00ff00ff
    s_mov_b32 exec_hi, 0xff00ff00
    s_nop 3
    ds_write_b128 v7, v[36:39] offset:0
    ds_write_b128 v7, v[40:43] offset:256
    ds_write_b128 v7, v[44:47] offset:512
    s_mov_b64 exec, 1
    ds_add_u32 v14, v15 offset:13000
    s_mov_b64 exec, -1
    buffer_load_dwordx4 v[108:111], v6, s[28:31], 0 offen offset:3840 nt
    buffer_load_dwordx4 v[172:175], v61, s[28:31], 0 offen offset:3840 nt
    s_waitcnt vmcnt(7)
    buffer_load_dwordx4 v[112:115], v6, s[28:31], s64 offen offset:0 nt
    s_waitcnt vmcnt(7)
    buffer_load_dwordx4 v[176:179], v61, s[28:31], s64 offen offset:0 nt
    s_waitcnt vmcnt(7)
    buffer_load_dwordx4 v[116:119], v6, s[28:31], s64 offen offset:1280 nt
    s_waitcnt vmcnt(7)
    buffer_load_dwordx4 v[180:183], v61, s[28:31], s64 offen offset:1280 nt
    s_waitcnt vmcnt(7)
    buffer_load_dwordx4 v[120:123], v6, s[28:31], s64 offen offset:2560 nt
    s_waitcnt vmcnt(7)
    buffer_load_dwordx4 v[184:187], v61, s[28:31], s64 offen offset:2560 nt
    s_waitcnt vmcnt(7)
    buffer_load_dwordx4 v[124:127], v6, s[28:31], s64 offen offset:3840 nt
    s_waitcnt vmcnt(7)
    buffer_load_dwordx4 v[188:191], v61, s[28:31], s64 offen offset:3840 nt
    s_waitcnt vmcnt(7)
    buffer_load_dwordx4 v[128:131], v6, s[28:31], s65 offen offset:0 nt
    s_waitcnt vmcnt(7)
    buffer_load_dwordx4 v[192:195], v61, s[28:31], s65 offen offset:0 nt
    s_waitcnt vmcnt(7)
    buffer_load_dwordx4 v[132:135], v6, s[28:31], s65 offen offset:1280 nt
    s_waitcnt vmcnt(7)
    buffer_load_dwordx4 v[196:199], v61, s[28:31], s65 offen offset:1280 nt
    s_waitcnt vmcnt(7)
    buffer_load_dwordx4 v[136:139], v6, s[28:31], s65 offen offset:2560 nt
    s_waitcnt vmcnt(7)
    buffer_load_dwordx4 v[200:203], v61, s[28:31], s65 offen offset:2560 nt
    s_waitcnt vmcnt(7)
    buffer_load_dwordx4 v[140:143], v6, s[28:31], s65 offen offset:3840 nt
    s_waitcnt vmcnt(7)
    buffer_load_dwordx4 v[204:207], v61, s[28:31], s65 offen offset:3840 nt
    s_mov_b32 s67, 6400000
L_owait0:
    ds_read_b128 v[52:55], v5 offset:12880
    ds_read_b128 v[48:51], v5 offset:12864
    s_sub_u32 s67, s67, 1
    s_cbranch_scc1 L_owait0_x
    s_waitcnt lgkmcnt(0)
    v_cmp_eq_u32 vcc, 0, v54
    s_cbranch_vccnz L_owait0
L_owait0_x:
    v_perm_b32 v208, v48, v48, v16
    v_perm_b32 v209, v48, v48, v17
    v_perm_b32 v210, v48, v48, v18
    v_perm_b32 v211, v48, v48, v19
    v_perm_b32 v212, v48, v48, v20
    v_perm_b32 v213, v48, v48, v21
    v_perm_b32 v214, v48, v48, v22
    v_perm_b32 v215, v48, v48, v23
    v_mfma_f32_16x16x32_bf16 v[36:39], v[208:211], v[96:99], 0
    v_mfma_f32_16x16x32_bf16 v[40:43], v[208:211], v[160:163], 0
    v_perm_b32 v216, v49, v49, v16
    v_perm_b32 v217, v49, v49, v17
    v_perm_b32 v218, v49, v49, v18
    v_perm_b32 v219, v49, v49, v19
    v_mfma_f32_16x16x32_bf16 v[36:39], v[212:215], v[100:103], v[36:39]
    v_mfma_f32_16x16x32_bf16 v[40:43], v[212:215], v[164:167], v[40:43]
    v_perm_b32 v220, v49, v49, v20
    v_perm_b32 v221, v49, v49, v21
    v_perm_b32 v222, v49, v49, v22
    v_perm_b32 v223, v49, v49, v23
    v_mfma_f32_16x16x32_bf16 v[36:39], v[216:219], v[104:107], v[36:39]
    v_mfma_f32_16x16x32_bf16 v[40:43], v[216:219], v[168:171], v[40:43]
    v_perm_b32 v208, v50, v50, v16
    v_perm_b32 v209, v50, v50, v17
    v_perm_b32 v210, v50, v50, v18
    v_perm_b32 v211, v50, v50, v19
    v_mfma_f32_16x16x32_bf16 v[36:39], v[220:223], v[108:111], v[36:39]
    v_mfma_f32_16x16x32_bf16 v[40:43], v[220:223], v[172:175], v[40:43]
    v_perm_b32 v212, v50, v50, v20
    v_perm_b32 v213, v50, v50, v21
    v_perm_b32 v214, v50, v50, v22
    v_perm_b32 v215, v50, v50, v23
    v_mfma_f32_16x16x32_bf16 v[36:39], v[208:211], v[112:115], v[36:39]
    v_mfma_f32_16x16x32_bf16 v[40:43], v[208:211], v[176:179], v[40:43]
    v_perm_b32 v216, v51, v51, v16
    v_perm_b32 v217, v51, v51, v17
    v_perm_b32 v218, v51, v51, v18
    v_perm_b32 v219, v51, v51, v19
    v_mfma_f32_16x16x32_bf16 v[36:39], v[212:215], v[116:119], v[36:39]
    v_mfma_f32_16x16x32_bf16 v[40:43], v[212:215], v[180:183], v[40:43]
    v_perm_b32 v220, v51, v51, v20
    v_perm_b32 v221, v51, v51, v21
    v_perm_b32 v222, v51, v51, v22
    v_perm_b32 v223, v51, v51, v23
    v_mfma_f32_16x16x32_bf16 v[36:39], v[216:219], v[120:123], v[36:39]
    v_mfma_f32_16x16x32_bf16 v[40:43], v[216:219], v[184:187], v[40:43]
    v_perm_b32 v208, v52, v52, v16
    v_perm_b32 v209, v52, v52, v17
    v_perm_b32 v210, v52, v52, v18
    v_perm_b32 v211, v52, v52, v19
    v_mfma_f32_16x16x32_bf16 v[36:39], v[220:223], v[124:127], v[36:39]
    v_mfma_f32_16x16x32_bf16 v[40:43], v[220:223], v[188:191], v[40:43]
    v_perm_b32 v212, v52, v52, v20
    v_perm_b32 v213, v52, v52, v21
    v_perm_b32 v214, v52, v52, v22
    v_perm_b32 v215, v52, v52, v23
    s_waitcnt vmcnt(7)
    v_mfma_f32_16x16x32_bf16 v[36:39], v[208:211], v[128:131], v[36:39]
    s_waitcnt vmcnt(6)
    v_mfma_f32_16x16x32_bf16 v[40:43], v[208:211], v[192:195], v[40:43]
    v_perm_b32 v216, v53, v53, v16
    v_perm_b32 v217, v53, v53, v17
    v_perm_b32 v218, v53, v53, v18
    v_perm_b32 v219, v53, v53, v19
    s_waitcnt vmcnt(5)
    v_mfma_f32_16x16x32_bf16 v[36:39], v[212:215], v[132:135], v[36:39]
    s_waitcnt vmcnt(4)
    v_mfma_f32_16x16x32_bf16 v[40:43], v[212:215], v[196:199], v[40:43]
    v_perm_b32 v220, v53, v53, v20
    v_perm_b32 v221, v53, v53, v21
    v_perm_b32 v222, v53, v53, v22
    v_perm_b32 v223, v53, v53, v23
    s_waitcnt vmcnt(3)
    v_mfma_f32_16x16x32_bf16 v[36:39], v[216:219], v[136:139], v[36:39]
    s_waitcnt vmcnt(2)
    v_mfma_f32_16x16x32_bf16 v[40:43], v[216:219], v[200:203], v[40:43]
    s_waitcnt vmcnt(1)
    v_mfma_f32_16x16x32_bf16 v[36:39], v[220:223], v[140:143], v[36:39]
    s_waitcnt vmcnt(0)
    v_mfma_f32_16x16x32_bf16 v[40:43], v[220:223], v[204:207], v[40:43]
    s_mov_b32 exec_hi, 0
    s_nop 5
    v_min_u32 v36, -2, v36
    v_min_u32 v37, -2, v37
    v_min_u32 v38, -2, v38
    v_min_u32 v39, -2, v39
    buffer_store_dwordx4 v[36:39], v4, s[36:39], s75 offen offset:1536 sc1
    v_min_u32 v40, -2, v40
    v_min_u32 v41, -2, v41
    v_min_u32 v42, -2, v42
    v_min_u32 v43, -2, v43
    buffer_store_dwordx4 v[40:43], v4, s[36:39], s75 offen offset:3584 sc1
    s_mov_b32 exec_hi, -1
    s_branch L_final
L_roleB:
    v_and_b32 v53, 15, v0
    v_lshlrev_b32 v53, 4, v53
    s_cmp_lg_u32 s58, 6
    s_cbranch_scc1 L_not6
    v_lshrrev_b32 v52, 4, v0
    s_mul_i32 s8, s57, 16384
    s_add_u32 s68, s55, 3
    v_sub_u32 v61, s68, v52
    v_and_b32 v61, 3, v61
    v_lshl_add_u32 v61, v61, 8, v53
    s_movk_i32 s68, 4096
    v_mad_u32_u24 v61, v52, s68, v61
    s_mov_b64 exec, s[4:5]
    buffer_load_dwordx4 v[96:99], v61, s[36:39], s8 offen offset:768 sc1
    s_mov_b64 exec, -1
    v_lshrrev_b32 v58, 2, v53
    v_bfe_u32 v15, v0, 4, 1
    v_lshl_add_u32 v58, v15, 1, v58
    v_lshrrev_b32 v15, 5, v0
    v_add_u32 v58, v58, v15
    v_mul_u32_u24 v15, 43, v58
    v_lshrrev_b32 v15, 9, v15
    v_lshlrev_b32 v58, 1, v58
    v_lshl_add_u32 v58, v15, 3, v58
    v_lshlrev_b32 v59, 5, v52
    v_mov_b32 v60, 1
    s_waitcnt vmcnt(3)
    v_mfma_f32_16x16x32_bf16 v[36:39], v[92:95], v[244:247], v[36:39]
    s_waitcnt vmcnt(2)
    v_mfma_f32_16x16x32_bf16 v[40:43], v[92:95], v[248:251], v[40:43]
    s_waitcnt vmcnt(1)
    v_mfma_f32_16x16x32_bf16 v[44:47], v[92:95], v[252:255], v[44:47]
    v_mov_b32 v14, 0
    v_mov_b32 v15, 1
    s_mov_b32 exec_lo, 0x00ff00ff
    s_mov_b32 exec_hi, 0xff00ff00
    s_nop 3
    ds_write_b128 v7, v[36:39] offset:0
    ds_write_b128 v7, v[40:43] offset:256
    ds_write_b128 v7, v[44:47] offset:512
    s_mov_b64 exec, 1
    ds_add_u32 v14, v15 offset:13000
    s_mov_b64 exec, -1
    s_mov_b64 exec, s[4:5]
    s_mov_b32 s67, 400000
    s_waitcnt vmcnt(0)
L_w6_poll:
    v_max3_u32 v15, v96, v97, v98
    v_max_u32 v15, v15, v99
    v_cmp_eq_u32 vcc, -1, v15
    s_cbranch_vccz L_w6_poll_ok
    s_mov_b64 exec, vcc
    buffer_load_dwordx4 v[96:99], v61, s[36:39], s8 offen offset:768 sc1
    s_sub_u32 s67, s67, 1
    s_waitcnt vmcnt(0)
    s_cbranch_scc0 L_w6_poll
L_w6_poll_ok:
    s_mov_b32 s67, 6400000
    s_mov_b64 exec, s[6:7]
L_w6_own:
    ds_read_b128 v[96:99], v53 offset:14080
    s_sub_u32 s67, s67, 1
    s_cbranch_scc1 L_w6_own_x
    s_waitcnt lgkmcnt(0)
    v_max3_u32 v15, v96, v97, v98
    v_max_u32 v15, v15, v99
    v_cmp_eq_u32 vcc, -1, v15
    s_cbranch_vccnz L_w6_own
L_w6_own_x:
    s_mov_b64 exec, -1
    v_mov_b32_dpp v31, v96 row_newbcast:12 row_mask:0xf bank_mask:0xf
    v_mov_b32_dpp v30, v96 row_newbcast:12 row_mask:0xf bank_mask:0xf
    v_mov_b32_dpp v28, v96 row_newbcast:12 row_mask:0xf bank_mask:0xf
    v_mov_b32_dpp v29, v97 row_newbcast:12 row_mask:0xf bank_mask:0xf
    v_permlane16_swap_b32 v31, v30
    v_max_f32 v31, v31, v30
    v_mov_b32 v30, v31
    s_nop 1
    v_permlane32_swap_b32 v31, v30
    v_max_f32 v31, v31, v30
    v_sub_f32 v28, v28, v31
    v_exp_f32 v28, v28
    s_nop 0
    v_mul_f32 v32, v29, v28
    v_mul_f32 v30, v29, v28
    v_mul_f32 v36, v96, v28
    v_mul_f32 v37, v97, v28
    v_mul_f32 v38, v98, v28
    v_mul_f32 v39, v99, v28
    v_permlane16_swap_b32 v32, v30
    v_add_f32 v32, v32, v30
    v_permlane32_swap_b32 v36, v37
    v_permlane32_swap_b32 v38, v39
    v_add_f32 v36, v36, v37
    v_add_f32 v38, v38, v39
    v_mov_b32 v30, v32
    s_nop 0
    v_permlane16_swap_b32 v36, v38
    v_add_f32 v36, v36, v38
    v_permlane32_swap_b32 v32, v30
    v_add_f32 v32, v32, v30
    v_rcp_f32 v32, v32
    s_mov_b32 exec_lo, 0x0fff0fff
    s_mov_b32 exec_hi, 0x0fff0fff
    v_mul_f32 v36, v36, v32
    v_cvt_pk_bf16_f32 v36, v36, v36
    ds_write_b16 v58, v36 offset:12864
    ds_write_b32 v59, v60 offset:12888
    s_mov_b64 exec, -1
    s_branch L_b5
L_not6:
    s_cmp_lg_u32 s58, 4
    s_cbranch_scc1 L_w57
    s_waitcnt vmcnt(2)
    v_mfma_f32_16x16x32_bf16 v[36:39], v[92:95], v[244:247], v[36:39]
    s_waitcnt vmcnt(1)
    v_mfma_f32_16x16x32_bf16 v[40:43], v[92:95], v[248:251], v[40:43]
    s_waitcnt vmcnt(0)
    v_mfma_f32_16x16x32_bf16 v[44:47], v[92:95], v[252:255], v[44:47]
    v_mov_b32 v14, 0
    v_mov_b32 v15, 1
    s_mov_b32 exec_lo, 0x00ff00ff
    s_mov_b32 exec_hi, 0xff00ff00
    s_nop 3
    ds_write_b128 v7, v[36:39] offset:0
    ds_write_b128 v7, v[40:43] offset:256
    ds_write_b128 v7, v[44:47] offset:512
    s_mov_b64 exec, 1
    ds_add_u32 v14, v15 offset:13000
    s_mov_b64 exec, -1
    s_branch L_b5
L_w57:
    v_lshrrev_b32 v52, 5, v0
    v_lshlrev_b32 v15, 4, v52
    v_mov_b32 v14, 0
    ds_read_b128 v[96:99], v14 offset:12800
    ds_read_b128 v[100:103], v14 offset:12816
    ds_read_b128 v[28:31], v15 offset:12800
    ds_read_b128 v[32:35], v15 offset:12832
    s_sub_u32 s68, 7, s58
    v_bfe_u32 v54, v0, 4, 1
    v_add_u32 v54, s68, v54
    v_mul_u32_u24 v58, 192, v54
    v_add_u32 v58, v58, v53
    s_movk_i32 s68, 6144
    v_mad_u32_u24 v58, v52, s68, v58
    v_lshl_add_u32 v55, v52, 3, v53
    s_sub_u32 s68, 3, s55
    v_add_u32 v59, s68, v54
    v_and_b32 v59, 3, v59
    v_lshl_add_u32 v59, v59, 8, v55
    s_movk_i32 s68, 192
    v_cmp_eq_u32 s[10:11], s68, v53
    v_cmp_eq_u32 s[6:7], s55, v54
    s_mov_b32 s4, 0x1fff1fff
    s_mov_b32 s5, 0x1fff1fff
    v_cmp_gt_u32 vcc, 32, v0
    s_waitcnt lgkmcnt(0)
    s_and_b64 s[6:7], s[6:7], s[4:5]
    s_andn2_b64 s[4:5], s[4:5], s[6:7]
    v_max3_f32 v56, v96, v97, v98
    v_max3_f32 v15, v99, v100, v101
    v_max3_f32 v56, v56, v102, v103
    v_max_f32 v56, v56, v15
    v_sub_f32 v28, v28, v56
    v_sub_f32 v29, v29, v56
    v_sub_f32 v30, v30, v56
    v_sub_f32 v31, v31, v56
    v_exp_f32 v28, v28
    v_exp_f32 v29, v29
    v_exp_f32 v30, v30
    v_exp_f32 v31, v31
    v_cndmask_b32 v56, 0, v56, vcc
    v_mul_f32 v57, v32, v28
    v_fmac_f32 v57, v33, v29
    v_fmac_f32 v57, v34, v30
    v_fmac_f32 v57, v35, v31
    s_waitcnt vmcnt(2)
    v_mfma_f32_16x16x32_bf16 v[36:39], v[92:95], v[244:247], v[36:39]
    s_waitcnt vmcnt(1)
    v_mfma_f32_16x16x32_bf16 v[40:43], v[92:95], v[248:251], v[40:43]
    s_waitcnt vmcnt(0)
    v_mfma_f32_16x16x32_bf16 v[44:47], v[92:95], v[252:255], v[44:47]
    v_mov_b32 v14, 0
    v_mov_b32 v15, 1
    s_mov_b32 exec_lo, 0x00ff00ff
    s_mov_b32 exec_hi, 0xff00ff00
    s_nop 3
    ds_write_b128 v7, v[36:39] offset:0
    ds_write_b128 v7, v[40:43] offset:256
    ds_write_b128 v7, v[44:47] offset:512
    s_mov_b64 exec, 1
    ds_add_u32 v14, v15 offset:13000
    s_mov_b64 exec, -1
    v_mov_b32 v14, 0
    s_mov_b32 s67, 6400000
L_w7_rows:
    ds_read_b32 v15, v14 offset:13000
    s_sub_u32 s67, s67, 1
    s_cbranch_scc1 L_w7_rows_x
    s_waitcnt lgkmcnt(0)
    v_cmp_gt_u32 vcc, 8, v15
    s_cbranch_vccnz L_w7_rows
L_w7_rows_x:
    ds_read_b128 v[160:163], v58 offset:0
    ds_read_b128 v[164:167], v58 offset:768
    ds_read_b128 v[168:171], v58 offset:1536
    ds_read_b128 v[172:175], v58 offset:2304
    ds_read_b128 v[176:179], v58 offset:3072
    ds_read_b128 v[180:183], v58 offset:3840
    ds_read_b128 v[184:187], v58 offset:4608
    ds_read_b128 v[188:191], v58 offset:5376
    s_waitcnt lgkmcnt(6)
    v_pk_add_f32 v[160:161], v[160:161], v[164:165]
    v_pk_add_f32 v[162:163], v[162:163], v[166:167]
    v_pk_mul_f32 v[36:37], v[160:161], v[28:29] op_sel_hi:[1,0]
    v_pk_mul_f32 v[38:39], v[162:163], v[28:29] op_sel_hi:[1,0]
    s_waitcnt lgkmcnt(4)
    v_pk_add_f32 v[168:169], v[168:169], v[172:173]
    v_pk_add_f32 v[170:171], v[170:171], v[174:175]
    v_pk_fma_f32 v[36:37], v[168:169], v[28:29], v[36:37] op_sel:[0,1,0] op_sel_hi:[1,1,1]
    v_pk_fma_f32 v[38:39], v[170:171], v[28:29], v[38:39] op_sel:[0,1,0] op_sel_hi:[1,1,1]
    s_waitcnt lgkmcnt(2)
    v_pk_add_f32 v[176:177], v[176:177], v[180:181]
    v_pk_add_f32 v[178:179], v[178:179], v[182:183]
    v_pk_fma_f32 v[36:37], v[176:177], v[30:31], v[36:37] op_sel_hi:[1,0,1]
    v_pk_fma_f32 v[38:39], v[178:179], v[30:31], v[38:39] op_sel_hi:[1,0,1]
    s_waitcnt lgkmcnt(0)
    v_pk_add_f32 v[184:185], v[184:185], v[188:189]
    v_pk_add_f32 v[186:187], v[186:187], v[190:191]
    v_pk_fma_f32 v[36:37], v[184:185], v[30:31], v[36:37] op_sel:[0,1,0] op_sel_hi:[1,1,1]
    v_pk_fma_f32 v[38:39], v[186:187], v[30:31], v[38:39] op_sel:[0,1,0] op_sel_hi:[1,1,1]
    v_cndmask_b32 v36, v36, v56, s[10:11]
    v_cndmask_b32 v37, v37, v57, s[10:11]
    s_nop 0
    v_permlane32_swap_b32 v36, v38
    v_permlane32_swap_b32 v37, v39
    v_pk_add_f32 v[36:37], v[36:37], v[38:39]
    v_min_u32 v36, -2, v36
    v_min_u32 v37, -2, v37
    s_mov_b64 exec, s[4:5]
    buffer_store_dwordx2 v[36:37], v59, s[36:39], s75 offen offset:768 sc1
    s_mov_b64 exec, s[6:7]
    s_cbranch_execz L_noown
    ds_write_b64 v55, v[36:37] offset:14080
L_noown:
    s_mov_b64 exec, -1
L_b5:
    s_cmp_ge_u32 s72, 20
    s_cbranch_scc1 L_done
    v_mov_b32 v14, 0
    s_mov_b32 s67, 6400000
L_late:
    ds_read_b32 v15, v14 offset:12888
    s_sub_u32 s67, s67, 1
    s_cbranch_scc1 L_late_x
    s_waitcnt lgkmcnt(0)
    v_cmp_gt_u32 vcc, 1, v15
    s_cbranch_vccnz L_late
L_late_x:
L_final:
    s_cmp_ge_u32 s72, 20
    s_cbranch_scc1 L_done
    v_lshrrev_b32 v14, 3, v0
    s_movk_i32 s68, 4096
    v_mad_u32_u24 v14, v14, s68, v9
    s_mul_i32 s68, s56, 524288
    s_mul_i32 s69, s58, 65536
    s_add_u32 s68, s68, s69
    s_lshl_b32 s69, s72, 7
    s_add_u32 s68, s68, s69
    s_add_u32 s68, s68, 1536
    s_add_u32 s69, s68, 32768
    buffer_load_dwordx4 v[224:227], v14, s[36:39], s68 offen sc1
    buffer_load_dwordx4 v[228:231], v14, s[36:39], s69 offen sc1
    v_lshlrev_b32 v52, 3, v9
    v_bfe_u32 v15, v0, 4, 1
    v_lshl_add_u32 v52, v15, 6, v52
    v_lshrrev_b32 v15, 5, v0
    v_lshl_add_u32 v52, v15, 5, v52
    s_lshl_b32 s70, s58, 2
    v_add_u32 v52, s70, v52
    v_lshlrev_b32 v53, 5, v0
    v_lshlrev_b32 v54, 1, v0
    v_mov_b32 v55, 0
    v_mov_b32 v56, 1
    s_mul_i32 s70, s56, 1280
    s_lshl_b32 s8, s72, 6
    s_add_u32 s70, s70, s8
    s_mov_b32 s67, 400000
    s_waitcnt vmcnt(0)
L_fin_poll:
    v_max3_u32 v15, v224, v225, v226
    v_max3_u32 v15, v15, v227, v228
    v_max3_u32 v15, v15, v229, v230
    v_max_u32 v15, v15, v231
    v_cmp_eq_u32 vcc, -1, v15
    s_cbranch_vccz L_fin_poll_ok
    s_mov_b64 exec, vcc
    buffer_load_dwordx4 v[224:227], v14, s[36:39], s68 offen sc1
    buffer_load_dwordx4 v[228:231], v14, s[36:39], s69 offen sc1
    s_sub_u32 s67, s67, 1
    s_waitcnt vmcnt(0)
    s_cbranch_scc0 L_fin_poll
L_fin_poll_ok:
    s_mov_b64 exec, -1
    v_pk_add_f32 v[224:225], v[224:225], v[228:229]
    v_pk_add_f32 v[226:227], v[226:227], v[230:231]
    s_nop 1
    v_permlane32_swap_b32 v224, v225
    v_permlane32_swap_b32 v226, v227
    v_add_f32 v224, v224, v225
    v_add_f32 v226, v226, v227
    s_nop 1
    v_permlane16_swap_b32 v224, v226
    v_add_f32 v224, v224, v226
    s_nop 1
    v_add_f32_dpp v224, v224, v224 row_ror:8 row_mask:0xf bank_mask:0xf
    ds_write_b32 v52, v224 offset:13056
    s_mov_b64 exec, 1
    ds_add_rtn_u32 v15, v55, v56 offset:13004
    s_mov_b32 exec_lo, -1
    ds_read_b128 v[224:227], v53 offset:13056
    ds_read_b128 v[228:231], v53 offset:13072
    s_waitcnt lgkmcnt(0)
    v_readfirstlane_b32 s68, v15
    s_cmp_lg_u32 s68, 7
    s_cbranch_scc1 L_done
    v_pk_add_f32 v[224:225], v[224:225], v[228:229]
    v_pk_add_f32 v[226:227], v[226:227], v[230:231]
    v_pk_add_f32 v[224:225], v[224:225], v[226:227]
    v_add_f32 v224, v224, v225
    v_cvt_pk_bf16_f32 v224, v224, v224
    buffer_store_short v224, v54, s[44:47], s70 offen
    s_mov_b32 exec_hi, -1
L_done:
L_end:
    s_endpgm
.section .rodata,"a"
.p2align 6
.amdhsa_kernel concat_heads__sliding_block_cached__sliding_block_cached__decode_kernel
  .amdhsa_next_free_vgpr 256
  .amdhsa_next_free_sgpr 80
  .amdhsa_accum_offset 256
  .amdhsa_group_segment_fixed_size 0
  .amdhsa_kernarg_size 104
  .amdhsa_user_sgpr_count 2
  .amdhsa_user_sgpr_kernarg_segment_ptr 1
  .amdhsa_system_sgpr_workgroup_id_x 1
  .amdhsa_float_denorm_mode_32 3
.end_amdhsa_kernel
```
